```python
import torch

def _softmax(x, axis=-1):
    return torch.softmax(x, dim=axis)

def _gelu(x):
    return torch.nn.functional.gelu(x, approximate='tanh')

def _silu(x):
    return torch.nn.functional.silu(x)

def _sigmoid(x):
    return torch.sigmoid(x)

def _layernorm(x, axis=-1, eps=1e-05):
    m = x.mean(dim=axis, keepdim=True)
    v = x.var(dim=axis, keepdim=True, unbiased=False)
    return (x - m) / torch.sqrt(v + eps)

def _scatter_add(tgt, idx, src, axis=0):
    return tgt.clone().index_add_(axis, idx, src)

def _segment_sum(src, seg, n):
    out = torch.zeros((n,) + src.shape[1:], dtype=src.dtype)
    return out.index_add_(0, seg, src)

def _pad(x, pw):
    flat = tuple((v for pair in reversed(pw) for v in pair))
    return torch.nn.functional.pad(x, flat)
kernel_name = 'standalone__tree_speculative_verify_tree_attention_over_candidate_token_tree__decode'

def setup_inputs():

    _w = lambda a: (lambda t: t.to(torch.bfloat16) if t.is_floating_point() else t)(torch.as_tensor(a))
    B, Hq, Hkv, T, C, D = (2, 32, 4, 1, 16384, 128)
    tree_mask = torch.zeros((B, T, T), dtype=float)
    for b in range(B):
        parent = torch.zeros(T, dtype=torch.int64)
        for i in range(1, T):
            parent[i] = int(torch.randint(0, i, (1,)).item())
        for i in range(T):
            j = i
            tree_mask[b, i, j] = 1.0
            while j > 0:
                j = parent[j]
                tree_mask[b, i, j] = 1.0
    return {'q': _w((lambda *s: torch.randn(*s, dtype=torch.bfloat16) * 0.8)(B, Hq, T, D)), 'k_cache': _w((lambda *s: torch.randn(*s, dtype=torch.bfloat16) * 0.8)(B, Hkv, C, D)), 'v_cache': _w((lambda *s: torch.randn(*s, dtype=torch.bfloat16) * 0.05)(B, Hkv, C, D)), 'k_tree': _w((lambda *s: torch.randn(*s, dtype=torch.bfloat16) * 0.8)(B, Hkv, T, D)), 'v_tree': _w((lambda *s: torch.randn(*s, dtype=torch.bfloat16) * 0.05)(B, Hkv, T, D)), 'tree_mask': _w(tree_mask)}

def reference(q, k_cache, v_cache, k_tree, v_tree, tree_mask):
    B, Hq, T, D = q.shape
    Hkv, C = (k_cache.shape[1], k_cache.shape[2])
    rep = Hq // Hkv
    kc = (lambda x, n, axis: torch.repeat_interleave(x, n, dim=axis))(k_cache, rep, axis=1)
    vc = (lambda x, n, axis: torch.repeat_interleave(x, n, dim=axis))(v_cache, rep, axis=1)
    kt = (lambda x, n, axis: torch.repeat_interleave(x, n, dim=axis))(k_tree, rep, axis=1)
    vt = (lambda x, n, axis: torch.repeat_interleave(x, n, dim=axis))(v_tree, rep, axis=1)
    k = torch.concatenate([kc, kt], axis=2)
    v = torch.concatenate([vc, vt], axis=2)
    scale = D ** (-0.5)
    scores = torch.einsum('bhqd,bhkd->bhqk', q, k) * scale
    ctx_mask = torch.ones((B, 1, T, C), dtype=scores.dtype)
    tm = tree_mask[:, None, :, :].clone()
    full_mask = torch.concatenate([ctx_mask, tm], axis=-1)
    scores = scores + (1.0 - full_mask) * -1000000000.0
    p = _softmax(scores, axis=-1)
    return torch.einsum('bhqk,bhkd->bhqd', p, v)
```

```asm
; @launch grid=(256,1,1) block=(320,1,1) lds=17408
.amdgcn_target "amdgcn-amd-amdhsa--gfx950"
.text
.globl standalone__tree_speculative_verify_tree_attention_over_candidate_token_tree__decode_kernel
.p2align 12
.type standalone__tree_speculative_verify_tree_attention_over_candidate_token_tree__decode_kernel,@function
standalone__tree_speculative_verify_tree_attention_over_candidate_token_tree__decode_kernel:
    s_load_dwordx16 s[4:19], s[0:1], 0
    s_load_dwordx2 s[20:21], s[0:1], 64
    s_cmp_ge_u32 s2, 256
    s_cbranch_scc1 L_end
    v_lshrrev_b32 v1, 6, v0
    v_and_b32 v0, 63, v0
    v_readfirstlane_b32 s3, v1
    s_and_b32 s22, s2, 7
    s_lshr_b32 s23, s2, 3
    s_lshl_b32 s36, s22, 22
    s_lshl_b32 s37, s23, 17
    s_add_u32 s36, s36, s37
    v_lshrrev_b32 v4, 4, v0
    v_lshlrev_b32 v2, 4, v0
    s_cmp_eq_u32 s3, 4
    s_cbranch_scc1 L_cons
    s_lshl_b32 s37, s3, 12
    s_add_u32 s36, s36, s37
    v_and_b32 v5, 8, v0
    v_lshlrev_b32 v4, 4, v4
    v_lshl_add_u32 v4, v5, 3, v4
    v_and_b32 v5, 3, v0
    v_bfe_u32 v6, v0, 2, 1
    v_lshl_add_u32 v5, v5, 2, v6
    v_lshl_add_u32 v1, v5, 8, v4
    v_and_b32 v5, 7, v0
    v_lshl_add_u32 v3, v5, 8, v4
    s_lshl_b32 s37, s22, 11
    v_add_u32 v3, s37, v3
    s_mov_b32 s41, 0x4000
    s_mov_b32 s42, 0x8000
    s_mov_b32 s43, 0xc000
    s_mov_b32 s44, 0x10000
    s_mov_b32 s45, 0x14000
    s_mov_b32 s46, 0x18000
    s_mov_b32 s47, 0x1c000
    s_mov_b32 s26, 0x1d000
    s_mov_b32 s27, 0x00020000
    s_mov_b32 s30, 0x1d000
    s_mov_b32 s31, 0x00020000
    s_waitcnt lgkmcnt(0)
    s_add_u32 s24, s6, s36
    s_addc_u32 s25, s7, 0
    buffer_load_dwordx4 v[128:131], v1, s[24:27], 0 offen offset:0 nt
    buffer_load_dwordx4 v[132:135], v1, s[24:27], 0 offen offset:128 nt
    buffer_load_dwordx4 v[136:139], v1, s[24:27], 0 offen offset:512 nt
    buffer_load_dwordx4 v[140:143], v1, s[24:27], 0 offen offset:640 nt
    s_add_u32 s28, s8, s36
    s_addc_u32 s29, s9, 0
    s_lshl_b32 s36, s3, 2
    v_lshl_add_u32 v61, v0, 5, s36
    global_load_dwordx4 v[8:11], v3, s[4:5] offset:0
    global_load_dwordx4 v[12:15], v3, s[4:5] offset:128
    s_mov_b32 s32, s20
    s_mov_b32 s33, s21
    s_mov_b32 s34, 0x108000
    s_mov_b32 s35, 0x00020000
    s_mul_i32 s36, s3, 4224
    v_add_u32 v62, s36, v2
    buffer_load_dwordx4 v[144:147], v1, s[24:27], s41 offen offset:0 nt
    buffer_load_dwordx4 v[148:151], v1, s[24:27], s41 offen offset:128 nt
    buffer_load_dwordx4 v[152:155], v1, s[24:27], s41 offen offset:512 nt
    buffer_load_dwordx4 v[156:159], v1, s[24:27], s41 offen offset:640 nt
    v_and_b32 v4, 3, v0
    v_mul_u32_u24 v63, 1056, v4
    buffer_load_dwordx4 v[160:163], v1, s[24:27], s42 offen offset:0 nt
    buffer_load_dwordx4 v[164:167], v1, s[24:27], s42 offen offset:128 nt
    buffer_load_dwordx4 v[168:171], v1, s[24:27], s42 offen offset:512 nt
    buffer_load_dwordx4 v[172:175], v1, s[24:27], s42 offen offset:640 nt
    v_bfe_u32 v4, v0, 2, 1
    v_lshl_add_u32 v63, v4, 7, v63
    buffer_load_dwordx4 v[176:179], v1, s[24:27], s43 offen offset:0 nt
    buffer_load_dwordx4 v[180:183], v1, s[24:27], s43 offen offset:128 nt
    buffer_load_dwordx4 v[184:187], v1, s[24:27], s43 offen offset:512 nt
    buffer_load_dwordx4 v[188:191], v1, s[24:27], s43 offen offset:640 nt
    v_lshrrev_b32 v6, 3, v0
    v_lshl_add_u32 v63, v6, 4, v63
    buffer_load_dwordx4 v[192:195], v1, s[24:27], s44 offen offset:0 nt
    buffer_load_dwordx4 v[196:199], v1, s[24:27], s44 offen offset:128 nt
    buffer_load_dwordx4 v[200:203], v1, s[24:27], s44 offen offset:512 nt
    buffer_load_dwordx4 v[204:207], v1, s[24:27], s44 offen offset:640 nt
    s_lshl_b32 s37, s3, 8
    v_add_u32 v63, s37, v63
    buffer_load_dwordx4 v[208:211], v1, s[24:27], s45 offen offset:0 nt
    buffer_load_dwordx4 v[212:215], v1, s[24:27], s45 offen offset:128 nt
    buffer_load_dwordx4 v[216:219], v1, s[24:27], s45 offen offset:512 nt
    buffer_load_dwordx4 v[220:223], v1, s[24:27], s45 offen offset:640 nt
    s_mov_b32 s48, 0x05040100
    s_mov_b32 s49, 0x07060302
    s_mov_b32 s52, 0x00ff00ff
    s_mov_b32 s53, 0x00ff00ff
    v_mul_u32_u24 v7, 16896, v6
    buffer_load_dwordx4 v[224:227], v1, s[24:27], s46 offen offset:0 nt
    buffer_load_dwordx4 v[228:231], v1, s[24:27], s46 offen offset:128 nt
    buffer_load_dwordx4 v[232:235], v1, s[24:27], s46 offen offset:512 nt
    buffer_load_dwordx4 v[236:239], v1, s[24:27], s46 offen offset:640 nt
    s_mov_b32 s50, 0x3e0293ee
    s_mul_i32 s37, s22, 135168
    s_add_u32 s36, s36, s37
    s_lshl_b32 s37, s23, 7
    s_add_u32 s36, s36, s37
    v_lshl_add_u32 v7, v5, 4, v7
    buffer_load_dwordx4 v[240:243], v1, s[24:27], s47 offen offset:0 nt
    buffer_load_dwordx4 v[244:247], v1, s[24:27], s47 offen offset:128 nt
    buffer_load_dwordx4 v[248:251], v1, s[24:27], s47 offen offset:512 nt
    buffer_load_dwordx4 v[252:255], v1, s[24:27], s47 offen offset:640 nt
    v_add_u32 v7, s36, v7
    buffer_load_dwordx4 v[64:67], v2, s[28:31], 0 offen offset:0 nt
    buffer_load_dwordx4 v[68:71], v2, s[28:31], 0 offen offset:1024 nt
    buffer_load_dwordx4 v[72:75], v2, s[28:31], 0 offen offset:2048 nt
    buffer_load_dwordx4 v[76:79], v2, s[28:31], 0 offen offset:3072 nt
    v_cndmask_b32 v56, 0, -1, s[52:53]
    v_cndmask_b32 v57, -1, 0, s[52:53]
    s_waitcnt vmcnt(32)
    v_mfma_f32_16x16x32_bf16 v[24:27], v[128:131], v[8:11], 0
    v_mfma_f32_16x16x32_bf16 v[40:43], v[136:139], v[8:11], 0
    v_mfma_f32_16x16x32_bf16 v[24:27], v[132:135], v[12:15], v[24:27]
    v_mfma_f32_16x16x32_bf16 v[40:43], v[140:143], v[12:15], v[40:43]
    s_waitcnt vmcnt(28)
    v_mfma_f32_16x16x32_bf16 v[44:47], v[144:147], v[8:11], 0
    v_mfma_f32_16x16x32_bf16 v[48:51], v[152:155], v[8:11], 0
    v_mfma_f32_16x16x32_bf16 v[44:47], v[148:151], v[12:15], v[44:47]
    v_mfma_f32_16x16x32_bf16 v[48:51], v[156:159], v[12:15], v[48:51]
    s_nop 2
    v_permlane32_swap_b32 v24, v40
    v_permlane32_swap_b32 v25, v41
    v_permlane32_swap_b32 v26, v42
    v_permlane32_swap_b32 v27, v43
    v_add_f32_dpp v24, v40, v24 row_ror:8 row_mask:0xf bank_mask:0x3
    v_add_f32_dpp v25, v41, v25 row_ror:8 row_mask:0xf bank_mask:0x3
    v_add_f32_dpp v26, v42, v26 row_ror:8 row_mask:0xf bank_mask:0x3
    v_add_f32_dpp v27, v43, v27 row_ror:8 row_mask:0xf bank_mask:0x3
    buffer_load_dwordx4 v[80:83], v2, s[28:31], s41 offen offset:0 nt
    buffer_load_dwordx4 v[84:87], v2, s[28:31], s41 offen offset:1024 nt
    buffer_load_dwordx4 v[88:91], v2, s[28:31], s41 offen offset:2048 nt
    buffer_load_dwordx4 v[92:95], v2, s[28:31], s41 offen offset:3072 nt
    s_waitcnt vmcnt(28)
    v_mfma_f32_16x16x32_bf16 v[28:31], v[160:163], v[8:11], 0
    v_mfma_f32_16x16x32_bf16 v[16:19], v[168:171], v[8:11], 0
    v_mfma_f32_16x16x32_bf16 v[28:31], v[164:167], v[12:15], v[28:31]
    v_mfma_f32_16x16x32_bf16 v[16:19], v[172:175], v[12:15], v[16:19]
    v_permlane32_swap_b32 v44, v48
    v_permlane32_swap_b32 v45, v49
    v_permlane32_swap_b32 v46, v50
    v_permlane32_swap_b32 v47, v51
    v_add_f32_dpp v24, v44, v48 row_ror:8 row_mask:0xf bank_mask:0xc
    v_add_f32_dpp v25, v45, v49 row_ror:8 row_mask:0xf bank_mask:0xc
    v_add_f32_dpp v26, v46, v50 row_ror:8 row_mask:0xf bank_mask:0xc
    v_add_f32_dpp v27, v47, v51 row_ror:8 row_mask:0xf bank_mask:0xc
    s_waitcnt vmcnt(24)
    v_mfma_f32_16x16x32_bf16 v[20:23], v[176:179], v[8:11], 0
    v_mfma_f32_16x16x32_bf16 v[52:55], v[184:187], v[8:11], 0
    v_mfma_f32_16x16x32_bf16 v[20:23], v[180:183], v[12:15], v[20:23]
    v_mfma_f32_16x16x32_bf16 v[52:55], v[188:191], v[12:15], v[52:55]
    v_permlane32_swap_b32 v28, v16
    v_permlane32_swap_b32 v29, v17
    v_permlane32_swap_b32 v30, v18
    v_permlane32_swap_b32 v31, v19
    v_add_f32_dpp v28, v16, v28 row_ror:8 row_mask:0xf bank_mask:0x3
    v_add_f32_dpp v29, v17, v29 row_ror:8 row_mask:0xf bank_mask:0x3
    v_add_f32_dpp v30, v18, v30 row_ror:8 row_mask:0xf bank_mask:0x3
    v_add_f32_dpp v31, v19, v31 row_ror:8 row_mask:0xf bank_mask:0x3
    buffer_load_dwordx4 v[96:99], v2, s[28:31], s42 offen offset:0 nt
    buffer_load_dwordx4 v[100:103], v2, s[28:31], s42 offen offset:1024 nt
    buffer_load_dwordx4 v[104:107], v2, s[28:31], s42 offen offset:2048 nt
    buffer_load_dwordx4 v[108:111], v2, s[28:31], s42 offen offset:3072 nt
    s_waitcnt vmcnt(24)
    v_mfma_f32_16x16x32_bf16 v[32:35], v[192:195], v[8:11], 0
    v_mfma_f32_16x16x32_bf16 v[40:43], v[200:203], v[8:11], 0
    v_mfma_f32_16x16x32_bf16 v[32:35], v[196:199], v[12:15], v[32:35]
    v_mfma_f32_16x16x32_bf16 v[40:43], v[204:207], v[12:15], v[40:43]
    v_permlane32_swap_b32 v20, v52
    v_permlane32_swap_b32 v21, v53
    v_permlane32_swap_b32 v22, v54
    v_permlane32_swap_b32 v23, v55
    v_add_f32_dpp v28, v20, v52 row_ror:8 row_mask:0xf bank_mask:0xc
    v_add_f32_dpp v29, v21, v53 row_ror:8 row_mask:0xf bank_mask:0xc
    v_add_f32_dpp v30, v22, v54 row_ror:8 row_mask:0xf bank_mask:0xc
    v_add_f32_dpp v31, v23, v55 row_ror:8 row_mask:0xf bank_mask:0xc
    buffer_load_dwordx4 v[112:115], v2, s[28:31], s43 offen offset:0 nt
    buffer_load_dwordx4 v[116:119], v2, s[28:31], s43 offen offset:1024 nt
    buffer_load_dwordx4 v[120:123], v2, s[28:31], s43 offen offset:2048 nt
    buffer_load_dwordx4 v[124:127], v2, s[28:31], s43 offen offset:3072 nt
    s_waitcnt vmcnt(24)
    v_mfma_f32_16x16x32_bf16 v[44:47], v[208:211], v[8:11], 0
    v_mfma_f32_16x16x32_bf16 v[48:51], v[216:219], v[8:11], 0
    v_mfma_f32_16x16x32_bf16 v[44:47], v[212:215], v[12:15], v[44:47]
    v_mfma_f32_16x16x32_bf16 v[48:51], v[220:223], v[12:15], v[48:51]
    v_permlane32_swap_b32 v32, v40
    v_permlane32_swap_b32 v33, v41
    v_permlane32_swap_b32 v34, v42
    v_permlane32_swap_b32 v35, v43
    v_add_f32_dpp v32, v40, v32 row_ror:8 row_mask:0xf bank_mask:0x3
    v_add_f32_dpp v33, v41, v33 row_ror:8 row_mask:0xf bank_mask:0x3
    v_add_f32_dpp v34, v42, v34 row_ror:8 row_mask:0xf bank_mask:0x3
    v_add_f32_dpp v35, v43, v35 row_ror:8 row_mask:0xf bank_mask:0x3
    v_max3_f32 v4, v24, v25, v26
    v_max3_f32 v5, v27, v28, v29
    v_max3_f32 v4, v4, v30, v31
    buffer_load_dwordx4 v[128:131], v2, s[28:31], s44 offen offset:0 nt
    buffer_load_dwordx4 v[132:135], v2, s[28:31], s44 offen offset:1024 nt
    buffer_load_dwordx4 v[136:139], v2, s[28:31], s44 offen offset:2048 nt
    buffer_load_dwordx4 v[140:143], v2, s[28:31], s44 offen offset:3072 nt
    s_waitcnt vmcnt(24)
    v_mfma_f32_16x16x32_bf16 v[36:39], v[224:227], v[8:11], 0
    v_mfma_f32_16x16x32_bf16 v[16:19], v[232:235], v[8:11], 0
    v_mfma_f32_16x16x32_bf16 v[36:39], v[228:231], v[12:15], v[36:39]
    v_mfma_f32_16x16x32_bf16 v[16:19], v[236:239], v[12:15], v[16:19]
    v_permlane32_swap_b32 v44, v48
    v_permlane32_swap_b32 v45, v49
    v_permlane32_swap_b32 v46, v50
    v_permlane32_swap_b32 v47, v51
    v_add_f32_dpp v32, v44, v48 row_ror:8 row_mask:0xf bank_mask:0xc
    v_add_f32_dpp v33, v45, v49 row_ror:8 row_mask:0xf bank_mask:0xc
    v_add_f32_dpp v34, v46, v50 row_ror:8 row_mask:0xf bank_mask:0xc
    v_add_f32_dpp v35, v47, v51 row_ror:8 row_mask:0xf bank_mask:0xc
    v_max3_f32 v5, v5, v32, v33
    v_max3_f32 v4, v4, v34, v35
    s_waitcnt vmcnt(20)
    v_mfma_f32_16x16x32_bf16 v[20:23], v[240:243], v[8:11], 0
    v_mfma_f32_16x16x32_bf16 v[52:55], v[248:251], v[8:11], 0
    v_mfma_f32_16x16x32_bf16 v[20:23], v[244:247], v[12:15], v[20:23]
    v_mfma_f32_16x16x32_bf16 v[52:55], v[252:255], v[12:15], v[52:55]
    v_permlane32_swap_b32 v36, v16
    v_permlane32_swap_b32 v37, v17
    v_permlane32_swap_b32 v38, v18
    v_permlane32_swap_b32 v39, v19
    v_add_f32_dpp v36, v16, v36 row_ror:8 row_mask:0xf bank_mask:0x3
    v_add_f32_dpp v37, v17, v37 row_ror:8 row_mask:0xf bank_mask:0x3
    v_add_f32_dpp v38, v18, v38 row_ror:8 row_mask:0xf bank_mask:0x3
    v_add_f32_dpp v39, v19, v39 row_ror:8 row_mask:0xf bank_mask:0x3
    buffer_load_dwordx4 v[144:147], v2, s[28:31], s45 offen offset:0 nt
    buffer_load_dwordx4 v[148:151], v2, s[28:31], s45 offen offset:1024 nt
    buffer_load_dwordx4 v[152:155], v2, s[28:31], s45 offen offset:2048 nt
    buffer_load_dwordx4 v[156:159], v2, s[28:31], s45 offen offset:3072 nt
    v_permlane32_swap_b32 v20, v52
    v_permlane32_swap_b32 v21, v53
    v_permlane32_swap_b32 v22, v54
    v_permlane32_swap_b32 v23, v55
    v_add_f32_dpp v36, v20, v52 row_ror:8 row_mask:0xf bank_mask:0xc
    v_add_f32_dpp v37, v21, v53 row_ror:8 row_mask:0xf bank_mask:0xc
    v_add_f32_dpp v38, v22, v54 row_ror:8 row_mask:0xf bank_mask:0xc
    v_add_f32_dpp v39, v23, v55 row_ror:8 row_mask:0xf bank_mask:0xc
    v_max3_f32 v5, v5, v36, v37
    v_max3_f32 v4, v4, v38, v39
    v_max_f32 v4, v4, v5
    v_mov_b32 v228, 0x3f803f80
    v_mov_b32 v229, 0x3f803f80
    v_max_f32_dpp v4, v4, v4 row_ror:8 row_mask:0xf bank_mask:0xf
    v_mov_b32 v5, v4
    s_nop 1
    v_permlane16_swap_b32 v4, v5
    v_max_f32 v4, v4, v5
    v_mov_b32 v5, v4
    s_nop 1
    v_permlane32_swap_b32 v4, v5
    v_max_f32 v4, v4, v5
    v_mul_f32 v232, s50, v4
    v_fma_f32 v24, v24, s50, -v232
    v_fma_f32 v25, v25, s50, -v232
    v_fma_f32 v26, v26, s50, -v232
    v_fma_f32 v27, v27, s50, -v232
    v_fma_f32 v28, v28, s50, -v232
    v_fma_f32 v29, v29, s50, -v232
    v_fma_f32 v30, v30, s50, -v232
    v_fma_f32 v31, v31, s50, -v232
    v_fma_f32 v32, v32, s50, -v232
    v_fma_f32 v33, v33, s50, -v232
    v_fma_f32 v34, v34, s50, -v232
    v_fma_f32 v35, v35, s50, -v232
    v_fma_f32 v36, v36, s50, -v232
    v_fma_f32 v37, v37, s50, -v232
    v_fma_f32 v38, v38, s50, -v232
    v_fma_f32 v39, v39, s50, -v232
    buffer_load_dwordx4 v[160:163], v2, s[28:31], s46 offen offset:0 nt
    buffer_load_dwordx4 v[164:167], v2, s[28:31], s46 offen offset:1024 nt
    buffer_load_dwordx4 v[168:171], v2, s[28:31], s46 offen offset:2048 nt
    buffer_load_dwordx4 v[172:175], v2, s[28:31], s46 offen offset:3072 nt
    v_exp_f32 v24, v24
    v_exp_f32 v25, v25
    v_exp_f32 v26, v26
    v_exp_f32 v27, v27
    v_exp_f32 v28, v28
    v_exp_f32 v29, v29
    v_exp_f32 v30, v30
    v_exp_f32 v31, v31
    v_exp_f32 v32, v32
    v_exp_f32 v33, v33
    v_exp_f32 v34, v34
    v_exp_f32 v35, v35
    v_exp_f32 v36, v36
    v_exp_f32 v37, v37
    v_exp_f32 v38, v38
    v_exp_f32 v39, v39
    buffer_load_dwordx4 v[176:179], v2, s[28:31], s47 offen offset:0 nt
    buffer_load_dwordx4 v[180:183], v2, s[28:31], s47 offen offset:1024 nt
    buffer_load_dwordx4 v[184:187], v2, s[28:31], s47 offen offset:2048 nt
    buffer_load_dwordx4 v[188:191], v2, s[28:31], s47 offen offset:3072 nt
    v_mov_b32 v230, 0x3f803f80
    v_mov_b32 v231, 0x3f803f80
    v_cvt_pk_bf16_f32 v24, v24, v25
    v_cvt_pk_bf16_f32 v26, v26, v27
    v_cvt_pk_bf16_f32 v28, v28, v29
    v_cvt_pk_bf16_f32 v30, v30, v31
    v_cvt_pk_bf16_f32 v32, v32, v33
    v_cvt_pk_bf16_f32 v34, v34, v35
    v_cvt_pk_bf16_f32 v36, v36, v37
    v_cvt_pk_bf16_f32 v38, v38, v39
    v_and_b32 v192, v24, v56
    v_and_b32 v193, v26, v56
    v_and_b32 v196, v28, v56
    v_and_b32 v197, v30, v56
    v_and_b32 v200, v32, v56
    v_and_b32 v201, v34, v56
    v_and_b32 v204, v36, v56
    v_and_b32 v205, v38, v56
    v_and_b32_dpp v194, v24, v56 row_ror:8 row_mask:0xf bank_mask:0xf
    v_and_b32_dpp v195, v26, v56 row_ror:8 row_mask:0xf bank_mask:0xf
    v_and_b32_dpp v198, v28, v56 row_ror:8 row_mask:0xf bank_mask:0xf
    v_and_b32_dpp v199, v30, v56 row_ror:8 row_mask:0xf bank_mask:0xf
    v_and_b32_dpp v202, v32, v56 row_ror:8 row_mask:0xf bank_mask:0xf
    v_and_b32_dpp v203, v34, v56 row_ror:8 row_mask:0xf bank_mask:0xf
    v_and_b32_dpp v206, v36, v56 row_ror:8 row_mask:0xf bank_mask:0xf
    v_and_b32_dpp v207, v38, v56 row_ror:8 row_mask:0xf bank_mask:0xf
    v_mfma_f32_16x16x32_bf16 v[236:239], v[228:231], v[192:195], 0
    v_mfma_f32_16x16x32_bf16 v[236:239], v[228:231], v[196:199], v[236:239]
    v_mfma_f32_16x16x32_bf16 v[236:239], v[228:231], v[200:203], v[236:239]
    v_mfma_f32_16x16x32_bf16 v[236:239], v[228:231], v[204:207], v[236:239]
    v_and_b32_dpp v208, v24, v57 row_ror:8 row_mask:0xf bank_mask:0xf
    v_and_b32_dpp v209, v26, v57 row_ror:8 row_mask:0xf bank_mask:0xf
    v_and_b32_dpp v212, v28, v57 row_ror:8 row_mask:0xf bank_mask:0xf
    v_and_b32_dpp v213, v30, v57 row_ror:8 row_mask:0xf bank_mask:0xf
    v_and_b32_dpp v216, v32, v57 row_ror:8 row_mask:0xf bank_mask:0xf
    v_and_b32_dpp v217, v34, v57 row_ror:8 row_mask:0xf bank_mask:0xf
    v_and_b32_dpp v220, v36, v57 row_ror:8 row_mask:0xf bank_mask:0xf
    v_and_b32_dpp v221, v38, v57 row_ror:8 row_mask:0xf bank_mask:0xf
    v_and_b32 v210, v24, v57
    v_and_b32 v211, v26, v57
    v_and_b32 v214, v28, v57
    v_and_b32 v215, v30, v57
    v_and_b32 v218, v32, v57
    v_and_b32 v219, v34, v57
    v_and_b32 v222, v36, v57
    v_and_b32 v223, v38, v57
    s_mov_b64 exec, 0xff
    ds_write2_b32 v61, v232, v236 offset0:0 offset1:4
    s_mov_b64 exec, -1
    v_lshlrev_b32 v61, 5, v6
    s_waitcnt lgkmcnt(0)
    s_barrier
    ds_read_b128 v[24:27], v61 offset:0
    ds_read_b128 v[28:31], v61 offset:16
    ds_read_b64 v[42:43], v61 offset:256
    s_waitcnt vmcnt(28)
    v_perm_b32 v224, v68, v64, s48
    v_perm_b32 v228, v68, v64, s49
    v_perm_b32 v232, v69, v65, s48
    v_perm_b32 v236, v69, v65, s49
    v_perm_b32 v240, v70, v66, s48
    v_perm_b32 v244, v70, v66, s49
    v_perm_b32 v248, v71, v67, s48
    v_perm_b32 v252, v71, v67, s49
    v_perm_b32 v225, v76, v72, s48
    v_perm_b32 v229, v76, v72, s49
    v_perm_b32 v233, v77, v73, s48
    v_perm_b32 v237, v77, v73, s49
    v_perm_b32 v241, v78, v74, s48
    v_perm_b32 v245, v78, v74, s49
    v_perm_b32 v249, v79, v75, s48
    v_perm_b32 v253, v79, v75, s49
    s_waitcnt vmcnt(24)
    v_perm_b32 v226, v84, v80, s48
    v_perm_b32 v230, v84, v80, s49
    v_perm_b32 v234, v85, v81, s48
    v_perm_b32 v238, v85, v81, s49
    v_perm_b32 v242, v86, v82, s48
    v_perm_b32 v246, v86, v82, s49
    v_perm_b32 v250, v87, v83, s48
    v_perm_b32 v254, v87, v83, s49
    v_perm_b32 v227, v92, v88, s48
    v_perm_b32 v231, v92, v88, s49
    v_perm_b32 v235, v93, v89, s48
    v_perm_b32 v239, v93, v89, s49
    v_perm_b32 v243, v94, v90, s48
    v_perm_b32 v247, v94, v90, s49
    v_perm_b32 v251, v95, v91, s48
    v_perm_b32 v255, v95, v91, s49
    v_mfma_f32_16x16x32_bf16 v[8:11], v[224:227], v[192:195], 0
    v_mfma_f32_16x16x32_bf16 v[12:15], v[228:231], v[192:195], 0
    v_mfma_f32_16x16x32_bf16 v[16:19], v[232:235], v[192:195], 0
    v_mfma_f32_16x16x32_bf16 v[20:23], v[236:239], v[192:195], 0
    v_mfma_f32_16x16x32_bf16 v[8:11], v[240:243], v[208:211], v[8:11]
    v_mfma_f32_16x16x32_bf16 v[12:15], v[244:247], v[208:211], v[12:15]
    v_mfma_f32_16x16x32_bf16 v[16:19], v[248:251], v[208:211], v[16:19]
    v_mfma_f32_16x16x32_bf16 v[20:23], v[252:255], v[208:211], v[20:23]
    s_waitcnt lgkmcnt(0)
    v_max3_f32 v4, v24, v25, v26
    v_readfirstlane_b32 s100, v42
    v_max_f32 v4, v4, v27
    v_sub_f32 v24, v24, v4
    v_sub_f32 v25, v25, v4
    v_sub_f32 v26, v26, v4
    v_sub_f32 v27, v27, v4
    v_exp_f32 v24, v24
    v_exp_f32 v25, v25
    v_exp_f32 v26, v26
    v_exp_f32 v27, v27
    v_mul_f32 v5, v28, v24
    v_fmac_f32 v5, v29, v25
    v_fmac_f32 v5, v30, v26
    v_fmac_f32 v5, v31, v27
    v_rcp_f32 v28, v5
    v_log_f32 v5, v5
    v_mul_f32 v24, v24, v28
    v_mul_f32 v25, v25, v28
    v_mul_f32 v26, v26, v28
    v_mul_f32 v27, v27, v28
    v_add_f32 v42, v4, v5
    s_waitcnt vmcnt(20)
    v_perm_b32 v224, v100, v96, s48
    v_perm_b32 v228, v100, v96, s49
    v_perm_b32 v232, v101, v97, s48
    v_perm_b32 v236, v101, v97, s49
    v_perm_b32 v240, v102, v98, s48
    v_perm_b32 v244, v102, v98, s49
    v_perm_b32 v248, v103, v99, s48
    v_perm_b32 v252, v103, v99, s49
    v_perm_b32 v225, v108, v104, s48
    v_perm_b32 v229, v108, v104, s49
    v_perm_b32 v233, v109, v105, s48
    v_perm_b32 v237, v109, v105, s49
    v_perm_b32 v241, v110, v106, s48
    v_perm_b32 v245, v110, v106, s49
    v_perm_b32 v249, v111, v107, s48
    v_perm_b32 v253, v111, v107, s49
    s_waitcnt vmcnt(16)
    v_perm_b32 v226, v116, v112, s48
    v_perm_b32 v230, v116, v112, s49
    v_perm_b32 v234, v117, v113, s48
    v_perm_b32 v238, v117, v113, s49
    v_perm_b32 v242, v118, v114, s48
    v_perm_b32 v246, v118, v114, s49
    v_perm_b32 v250, v119, v115, s48
    v_perm_b32 v254, v119, v115, s49
    v_perm_b32 v227, v124, v120, s48
    v_perm_b32 v231, v124, v120, s49
    v_perm_b32 v235, v125, v121, s48
    v_perm_b32 v239, v125, v121, s49
    v_perm_b32 v243, v126, v122, s48
    v_perm_b32 v247, v126, v122, s49
    v_perm_b32 v251, v127, v123, s48
    v_perm_b32 v255, v127, v123, s49
    v_mfma_f32_16x16x32_bf16 v[8:11], v[224:227], v[196:199], v[8:11]
    v_mfma_f32_16x16x32_bf16 v[12:15], v[228:231], v[196:199], v[12:15]
    v_mfma_f32_16x16x32_bf16 v[16:19], v[232:235], v[196:199], v[16:19]
    v_mfma_f32_16x16x32_bf16 v[20:23], v[236:239], v[196:199], v[20:23]
    v_mfma_f32_16x16x32_bf16 v[8:11], v[240:243], v[212:215], v[8:11]
    v_mfma_f32_16x16x32_bf16 v[12:15], v[244:247], v[212:215], v[12:15]
    v_mfma_f32_16x16x32_bf16 v[16:19], v[248:251], v[212:215], v[16:19]
    v_mfma_f32_16x16x32_bf16 v[20:23], v[252:255], v[212:215], v[20:23]
    s_waitcnt vmcnt(12)
    v_perm_b32 v224, v132, v128, s48
    v_perm_b32 v228, v132, v128, s49
    v_perm_b32 v232, v133, v129, s48
    v_perm_b32 v236, v133, v129, s49
    v_perm_b32 v240, v134, v130, s48
    v_perm_b32 v244, v134, v130, s49
    v_perm_b32 v248, v135, v131, s48
    v_perm_b32 v252, v135, v131, s49
    v_perm_b32 v225, v140, v136, s48
    v_perm_b32 v229, v140, v136, s49
    v_perm_b32 v233, v141, v137, s48
    v_perm_b32 v237, v141, v137, s49
    v_perm_b32 v241, v142, v138, s48
    v_perm_b32 v245, v142, v138, s49
    v_perm_b32 v249, v143, v139, s48
    v_perm_b32 v253, v143, v139, s49
    s_waitcnt vmcnt(8)
    v_perm_b32 v226, v148, v144, s48
    v_perm_b32 v230, v148, v144, s49
    v_perm_b32 v234, v149, v145, s48
    v_perm_b32 v238, v149, v145, s49
    v_perm_b32 v242, v150, v146, s48
    v_perm_b32 v246, v150, v146, s49
    v_perm_b32 v250, v151, v147, s48
    v_perm_b32 v254, v151, v147, s49
    v_perm_b32 v227, v156, v152, s48
    v_perm_b32 v231, v156, v152, s49
    v_perm_b32 v235, v157, v153, s48
    v_perm_b32 v239, v157, v153, s49
    v_perm_b32 v243, v158, v154, s48
    v_perm_b32 v247, v158, v154, s49
    v_perm_b32 v251, v159, v155, s48
    v_perm_b32 v255, v159, v155, s49
    v_mfma_f32_16x16x32_bf16 v[8:11], v[224:227], v[200:203], v[8:11]
    v_mfma_f32_16x16x32_bf16 v[12:15], v[228:231], v[200:203], v[12:15]
    v_mfma_f32_16x16x32_bf16 v[16:19], v[232:235], v[200:203], v[16:19]
    v_mfma_f32_16x16x32_bf16 v[20:23], v[236:239], v[200:203], v[20:23]
    v_mfma_f32_16x16x32_bf16 v[8:11], v[240:243], v[216:219], v[8:11]
    v_mfma_f32_16x16x32_bf16 v[12:15], v[244:247], v[216:219], v[12:15]
    v_mfma_f32_16x16x32_bf16 v[16:19], v[248:251], v[216:219], v[16:19]
    v_mfma_f32_16x16x32_bf16 v[20:23], v[252:255], v[216:219], v[20:23]
    s_waitcnt vmcnt(6)
    v_perm_b32 v224, v164, v160, s48
    v_perm_b32 v228, v164, v160, s49
    v_perm_b32 v232, v165, v161, s48
    v_perm_b32 v236, v165, v161, s49
    v_perm_b32 v240, v166, v162, s48
    v_perm_b32 v244, v166, v162, s49
    v_perm_b32 v248, v167, v163, s48
    v_perm_b32 v252, v167, v163, s49
    s_waitcnt vmcnt(4)
    v_perm_b32 v225, v172, v168, s48
    v_perm_b32 v229, v172, v168, s49
    v_perm_b32 v233, v173, v169, s48
    v_perm_b32 v237, v173, v169, s49
    v_perm_b32 v241, v174, v170, s48
    v_perm_b32 v245, v174, v170, s49
    v_perm_b32 v249, v175, v171, s48
    v_perm_b32 v253, v175, v171, s49
    s_waitcnt vmcnt(2)
    v_perm_b32 v226, v180, v176, s48
    v_perm_b32 v230, v180, v176, s49
    v_perm_b32 v234, v181, v177, s48
    v_perm_b32 v238, v181, v177, s49
    v_perm_b32 v242, v182, v178, s48
    v_perm_b32 v246, v182, v178, s49
    v_perm_b32 v250, v183, v179, s48
    v_perm_b32 v254, v183, v179, s49
    s_waitcnt vmcnt(0)
    v_perm_b32 v227, v188, v184, s48
    v_perm_b32 v231, v188, v184, s49
    v_perm_b32 v235, v189, v185, s48
    v_perm_b32 v239, v189, v185, s49
    v_perm_b32 v243, v190, v186, s48
    v_perm_b32 v247, v190, v186, s49
    v_perm_b32 v251, v191, v187, s48
    v_perm_b32 v255, v191, v187, s49
    v_mfma_f32_16x16x32_bf16 v[8:11], v[224:227], v[204:207], v[8:11]
    v_mfma_f32_16x16x32_bf16 v[12:15], v[228:231], v[204:207], v[12:15]
    v_mfma_f32_16x16x32_bf16 v[16:19], v[232:235], v[204:207], v[16:19]
    v_mfma_f32_16x16x32_bf16 v[20:23], v[236:239], v[204:207], v[20:23]
    v_mfma_f32_16x16x32_bf16 v[8:11], v[240:243], v[220:223], v[8:11]
    v_mfma_f32_16x16x32_bf16 v[12:15], v[244:247], v[220:223], v[12:15]
    v_mfma_f32_16x16x32_bf16 v[16:19], v[248:251], v[220:223], v[16:19]
    v_mfma_f32_16x16x32_bf16 v[20:23], v[252:255], v[220:223], v[20:23]
    s_nop 4
    ds_write_b128 v62, v[8:11] offset:512
    ds_write_b128 v62, v[12:15] offset:1568
    ds_write_b128 v62, v[16:19] offset:2624
    ds_write_b128 v62, v[20:23] offset:3680
    s_waitcnt lgkmcnt(0)
    s_barrier
    ds_read_b128 v[224:227], v63 offset:512
    ds_read_b128 v[228:231], v63 offset:4736
    ds_read_b128 v[232:235], v63 offset:8960
    ds_read_b128 v[236:239], v63 offset:13184
    s_cmp_lg_u32 s100, 0
    s_waitcnt lgkmcnt(3)
    v_pk_mul_f32 v[224:225], v[224:225], v[24:25] op_sel:[0,0] op_sel_hi:[1,0]
    v_pk_mul_f32 v[226:227], v[226:227], v[24:25] op_sel:[0,0] op_sel_hi:[1,0]
    s_waitcnt lgkmcnt(2)
    v_pk_fma_f32 v[224:225], v[228:229], v[24:25], v[224:225] op_sel:[0,1,0] op_sel_hi:[1,1,1]
    v_pk_fma_f32 v[226:227], v[230:231], v[24:25], v[226:227] op_sel:[0,1,0] op_sel_hi:[1,1,1]
    s_waitcnt lgkmcnt(1)
    v_pk_fma_f32 v[224:225], v[232:233], v[26:27], v[224:225] op_sel:[0,0,0] op_sel_hi:[1,0,1]
    v_pk_fma_f32 v[226:227], v[234:235], v[26:27], v[226:227] op_sel:[0,0,0] op_sel_hi:[1,0,1]
    s_waitcnt lgkmcnt(0)
    v_pk_fma_f32 v[224:225], v[236:237], v[26:27], v[224:225] op_sel:[0,1,0] op_sel_hi:[1,1,1]
    v_pk_fma_f32 v[226:227], v[238:239], v[26:27], v[226:227] op_sel:[0,1,0] op_sel_hi:[1,1,1]
    v_cvt_pk_bf16_f32 v40, v224, v225
    v_cvt_pk_bf16_f32 v41, v226, v227
    s_cbranch_scc0 L_slow
    buffer_store_dwordx4 v[40:43], v7, s[32:35], 0 offen
    s_endpgm
L_slow:
    buffer_store_dwordx4 v[40:43], v7, s[32:35], 0 offen sc1
L_end:
    s_endpgm
.p2align 6
L_cons:
    s_setprio 3
    s_lshr_b32 s36, s23, 2
    s_and_b32 s39, s23, 3
    s_lshl_b32 s37, s22, 3
    s_add_u32 s37, s37, s36
    s_lshl_b32 s61, s37, 8
    s_mul_i32 s55, s22, 135168
    s_add_u32 s96, s55, 8320
    v_lshlrev_b32 v6, 2, v0
    v_add_u32 v8, s61, v6
    s_lshl_b32 s38, s22, 8
    v_add_u32 v9, s38, v6
    v_and_b32 v5, 7, v0
    v_lshl_add_u32 v5, v4, 3, v5
    s_lshl_b32 s36, s39, 5
    v_add_lshl_u32 v5, v5, s36, 1
    v_add_u32 v11, s61, v5
    v_add_u32 v10, s38, v5
    s_waitcnt lgkmcnt(0)
    s_load_dword s59, s[20:21], s96
    s_load_dword s54, s[14:15], 0
    global_load_dword v8, v8, s[4:5]
    global_load_dword v9, v9, s[10:11]
    global_load_ushort v10, v10, s[12:13]
    s_mov_b32 s32, s20
    s_mov_b32 s33, s21
    s_mov_b32 s34, 0x108000
    s_mov_b32 s35, 0x00020000
    s_mul_i32 s36, s23, 4224
    s_add_u32 s36, s36, s55
    v_lshl_add_u32 v15, v0, 7, s36
    v_and_b32 v12, 7, v0
    s_add_u32 s98, s55, 12544
    v_mov_b32 v13, 4224
    v_mad_u32_u24 v12, v12, v13, s98
    v_cmp_gt_u32 vcc, 32, v0
    s_nop 1
    v_cndmask_b32 v15, v12, v15, vcc
    buffer_load_dword v15, v15, s[32:35], 0 offen sc1
    s_getreg_b32 s99, hwreg(HW_REG_XCC_ID, 0, 4)
    s_mul_i32 s36, s23, 4224
    s_add_u32 s36, s36, s55
    v_add_u32 v7, s36, v2
    s_add_u32 s37, s55, 4096
    v_lshlrev_b32 v14, 5, v0
    s_lshl_b32 s38, s23, 2
    s_add_u32 s37, s37, s38
    s_waitcnt lgkmcnt(0)
    s_mul_i32 s51, s59, 0x9e3779b1
    s_add_u32 s51, s51, 0x7f4a7c15
    s_add_u32 s99, s99, s51
    v_mov_b32 v13, s99
    s_mov_b32 s48, s99
    s_mov_b32 s49, s99
    s_mov_b64 exec, 0xff
    buffer_store_dword v13, v12, s[32:35], s38 offen
    s_mov_b64 exec, -1
    v_mov_b32 v17, s51
    s_lshr_b32 s36, s22, 2
    s_lshl_b32 s36, s36, 4
    s_lshr_b32 s36, s54, s36
    s_lshl_b32 s36, s36, 16
    s_waitcnt vmcnt(0)
    v_lshlrev_b32 v4, 16, v8
    v_lshlrev_b32 v5, 16, v9
    v_and_b32 v8, 0xffff0000, v8
    v_and_b32 v9, 0xffff0000, v9
    v_mul_f32 v4, v4, v5
    v_fmac_f32 v4, v8, v9
    v_lshlrev_b32 v10, 16, v10
    s_nop 0
    v_add_f32_dpp v4, v4, v4 row_ror:8 row_mask:0xf bank_mask:0xf
    s_nop 1
    v_add_f32_dpp v4, v4, v4 row_ror:4 row_mask:0xf bank_mask:0xf
    s_nop 1
    v_add_f32_dpp v4, v4, v4 row_ror:2 row_mask:0xf bank_mask:0xf
    s_nop 1
    v_add_f32_dpp v4, v4, v4 row_ror:1 row_mask:0xf bank_mask:0xf
    v_mov_b32 v5, v4
    s_nop 1
    v_permlane16_swap_b32 v4, v5
    v_add_f32 v4, v4, v5
    v_mov_b32 v5, v4
    s_nop 1
    v_permlane32_swap_b32 v4, v5
    v_add_f32 v4, v4, v5
    v_mov_b32 v5, s36
    v_sub_f32 v5, 1.0, v5
    v_mul_f32 v5, 0xceabfb8f, v5
    v_mov_b32 v6, 0x3e0293ee
    v_fma_f32 v8, v4, v6, v5
    s_mov_b32 s52, 0x00ff00ff
    s_mov_b32 s53, 0x00ff00ff
    s_mov_b32 s97, 1
L_dry:
    s_mov_b32 s97, 0
    s_mov_b32 s57, 7
L_xt:
    s_load_dwordx8 s[4:11], s[20:21], s98
    s_add_u32 s98, s98, 32
    s_load_dwordx8 s[24:31], s[20:21], s98
    s_add_u32 s98, s98, 32
    s_load_dwordx8 s[40:47], s[20:21], s98
    s_add_u32 s98, s98, 32
    s_load_dwordx8 s[68:75], s[20:21], s98
    s_add_u32 s98, s98, 4128
    s_mov_b32 s100, 1
    s_waitcnt lgkmcnt(0)
    s_xor_b64 s[4:5], s[4:5], s[48:49]
    s_xor_b64 s[6:7], s[6:7], s[48:49]
    s_xor_b64 s[8:9], s[8:9], s[48:49]
    s_xor_b64 s[10:11], s[10:11], s[48:49]
    s_xor_b64 s[24:25], s[24:25], s[48:49]
    s_xor_b64 s[26:27], s[26:27], s[48:49]
    s_xor_b64 s[28:29], s[28:29], s[48:49]
    s_xor_b64 s[30:31], s[30:31], s[48:49]
    s_xor_b64 s[40:41], s[40:41], s[48:49]
    s_xor_b64 s[42:43], s[42:43], s[48:49]
    s_xor_b64 s[44:45], s[44:45], s[48:49]
    s_xor_b64 s[46:47], s[46:47], s[48:49]
    s_xor_b64 s[68:69], s[68:69], s[48:49]
    s_xor_b64 s[70:71], s[70:71], s[48:49]
    s_xor_b64 s[72:73], s[72:73], s[48:49]
    s_xor_b64 s[74:75], s[74:75], s[48:49]
    s_or_b64 s[4:5], s[4:5], s[6:7]
    s_or_b64 s[4:5], s[4:5], s[8:9]
    s_or_b64 s[4:5], s[4:5], s[10:11]
    s_or_b64 s[4:5], s[4:5], s[24:25]
    s_or_b64 s[4:5], s[4:5], s[26:27]
    s_or_b64 s[4:5], s[4:5], s[28:29]
    s_or_b64 s[4:5], s[4:5], s[30:31]
    s_or_b64 s[4:5], s[4:5], s[40:41]
    s_or_b64 s[4:5], s[4:5], s[42:43]
    s_or_b64 s[4:5], s[4:5], s[44:45]
    s_or_b64 s[4:5], s[4:5], s[46:47]
    s_or_b64 s[4:5], s[4:5], s[68:69]
    s_or_b64 s[4:5], s[4:5], s[70:71]
    s_or_b64 s[4:5], s[4:5], s[72:73]
    s_or_b64 s[4:5], s[4:5], s[74:75]
    s_cbranch_scc0 L_xok
    s_mov_b32 s100, 0
    s_sub_u32 s57, s57, 1
    s_cbranch_scc0 L_xt
L_xok:
    v_mov_b32 v16, s100
    s_mov_b64 exec, 0xff
    ds_write_b64 v14, v[16:17] offset:256
    s_mov_b64 exec, -1
    s_mov_b32 s57, 0x30d40
    s_waitcnt lgkmcnt(0)
    s_barrier
    s_barrier
    buffer_load_dwordx4 v[20:23], v7, s[32:35], 0 offen offset:0 sc1
    buffer_load_dwordx4 v[24:27], v7, s[32:35], 0 offen offset:1024 sc1
    buffer_load_dwordx4 v[28:31], v7, s[32:35], 0 offen offset:2048 sc1
    buffer_load_dwordx4 v[32:35], v7, s[32:35], 0 offen offset:3072 sc1
L_chk:
    s_waitcnt vmcnt(0)
    v_xor_b32 v4, s51, v23
    v_bitop3_b32 v4, v27, s51, v4 bitop3:0xbe
    v_bitop3_b32 v4, v31, s51, v4 bitop3:0xbe
    v_bitop3_b32 v4, v35, s51, v4 bitop3:0xbe
    v_cmp_ne_u32 vcc, 0, v4
    s_cbranch_vccz L_ok
    s_mov_b64 exec, vcc
    buffer_load_dwordx4 v[20:23], v7, s[32:35], 0 offen offset:0 sc1
    buffer_load_dwordx4 v[24:27], v7, s[32:35], 0 offen offset:1024 sc1
    buffer_load_dwordx4 v[28:31], v7, s[32:35], 0 offen offset:2048 sc1
    buffer_load_dwordx4 v[32:35], v7, s[32:35], 0 offen offset:3072 sc1
    s_mov_b64 exec, -1
    s_sub_u32 s57, s57, 1
    s_cbranch_scc0 L_chk
    s_endpgm
L_ok:
    v_max3_f32 v4, v22, v26, v8
    v_max3_f32 v4, v30, v34, v4
    v_lshlrev_b32 v36, 16, v20
    v_and_b32 v37, 0xffff0000, v20
    v_max_f32_dpp v4, v4, v4 row_ror:8 row_mask:0xf bank_mask:0xf
    v_mov_b32 v5, v4
    v_lshlrev_b32 v38, 16, v21
    v_and_b32 v39, 0xffff0000, v21
    v_permlane16_swap_b32 v4, v5
    v_max_f32 v4, v4, v5
    v_mov_b32 v5, v4
    v_lshlrev_b32 v40, 16, v24
    v_and_b32 v41, 0xffff0000, v24
    v_permlane32_swap_b32 v4, v5
    v_max_f32 v4, v4, v5
    v_sub_f32 v52, v22, v4
    v_sub_f32 v53, v26, v4
    v_sub_f32 v54, v30, v4
    v_sub_f32 v55, v34, v4
    v_sub_f32 v62, v8, v4
    v_exp_f32 v52, v52
    v_lshlrev_b32 v42, 16, v25
    v_and_b32 v43, 0xffff0000, v25
    v_exp_f32 v53, v53
    v_lshlrev_b32 v44, 16, v28
    v_and_b32 v45, 0xffff0000, v28
    v_exp_f32 v54, v54
    v_lshlrev_b32 v46, 16, v29
    v_and_b32 v47, 0xffff0000, v29
    v_exp_f32 v55, v55
    v_lshlrev_b32 v48, 16, v32
    v_and_b32 v49, 0xffff0000, v32
    v_exp_f32 v62, v62
    v_lshlrev_b32 v50, 16, v33
    v_and_b32 v51, 0xffff0000, v33
    v_add_f32 v60, v52, v53
    v_add_f32 v61, v54, v55
    v_pk_mul_f32 v[56:57], v[36:37], v[52:53] op_sel:[0,0] op_sel_hi:[1,0]
    v_pk_mul_f32 v[58:59], v[38:39], v[52:53] op_sel:[0,0] op_sel_hi:[1,0]
    v_add_f32 v60, v60, v61
    v_pk_fma_f32 v[56:57], v[40:41], v[52:53], v[56:57] op_sel:[0,1,0] op_sel_hi:[1,1,1]
    v_pk_fma_f32 v[58:59], v[42:43], v[52:53], v[58:59] op_sel:[0,1,0] op_sel_hi:[1,1,1]
    v_add_f32_dpp v60, v60, v60 row_ror:8 row_mask:0xf bank_mask:0xf
    v_pk_fma_f32 v[56:57], v[44:45], v[54:55], v[56:57] op_sel:[0,0,0] op_sel_hi:[1,0,1]
    v_pk_fma_f32 v[58:59], v[46:47], v[54:55], v[58:59] op_sel:[0,0,0] op_sel_hi:[1,0,1]
    v_mov_b32 v61, v60
    v_pk_fma_f32 v[56:57], v[48:49], v[54:55], v[56:57] op_sel:[0,1,0] op_sel_hi:[1,1,1]
    v_pk_fma_f32 v[58:59], v[50:51], v[54:55], v[58:59] op_sel:[0,1,0] op_sel_hi:[1,1,1]
    v_permlane16_swap_b32 v60, v61
    v_add_f32 v60, v60, v61
    v_permlane32_swap_b32 v56, v58
    v_permlane32_swap_b32 v57, v59
    v_mov_b32 v61, v60
    v_pk_add_f32 v[56:57], v[56:57], v[58:59]
    s_cmp_lg_u32 s97, 0
    v_permlane32_swap_b32 v60, v61
    v_permlane16_swap_b32 v56, v57
    v_add_f32 v60, v60, v61
    v_add_f32 v60, v60, v62
    v_add_f32 v56, v56, v57
    v_rcp_f32 v60, v60
    s_nop 0
    v_add_f32_dpp v56, v56, v56 row_ror:8 row_mask:0xf bank_mask:0xf
    v_fmac_f32 v56, v62, v10
    v_mul_f32 v56, v56, v60
    v_cvt_pk_bf16_f32 v56, v56, v56
    s_mov_b64 exec, s[52:53]
    global_store_short v11, v56, s[16:17]
    s_cmp_lg_u32 s23, 0
    s_cbranch_scc1 L_done
    s_mov_b64 exec, 1
    buffer_store_dword v17, off, s[32:35], s96 sc1
L_done:
    s_endpgm
.section .rodata,"a"
.p2align 6
.amdhsa_kernel standalone__tree_speculative_verify_tree_attention_over_candidate_token_tree__decode_kernel
  .amdhsa_next_free_vgpr 256
  .amdhsa_next_free_sgpr 102
  .amdhsa_accum_offset 256
  .amdhsa_group_segment_fixed_size 0
  .amdhsa_kernarg_size 72
  .amdhsa_user_sgpr_count 2
  .amdhsa_user_sgpr_kernarg_segment_ptr 1
  .amdhsa_system_sgpr_workgroup_id_x 1
.end_amdhsa_kernel
```
